```python
import torch

def _softmax(x, axis=-1):
    return torch.softmax(x, dim=axis)
def _gelu(x):
    return torch.nn.functional.gelu(x, approximate="tanh")
def _silu(x):
    return torch.nn.functional.silu(x)
def _sigmoid(x):
    return torch.sigmoid(x)
def _layernorm(x, axis=-1, eps=1e-5):
    m = x.mean(dim=axis, keepdim=True)
    v = x.var(dim=axis, keepdim=True, unbiased=False)
    return (x - m) / torch.sqrt(v + eps)
def _scatter_add(tgt, idx, src, axis=0):
    return tgt.clone().index_add_(axis, idx, src)
def _segment_sum(src, seg, n):
    out = torch.zeros((n,) + src.shape[1:], dtype=src.dtype)
    return out.index_add_(0, seg, src)
def _pad(x, pw):
    flat = tuple(v for pair in reversed(pw) for v in pair)
    return torch.nn.functional.pad(x, flat)

kernel_name = 'sequential_preLN__sliding_block_cached__glu_gated_reglu__decode'

def setup_inputs():

    _w = (lambda a: (lambda t: t.to(torch.bfloat16) if t.is_floating_point() else t)(torch.as_tensor(a)))
    def _A_setup():
        B, Sq, D = 1, 1, 1024
        Hq, Hkv, Sk, Dh = 32, 4, 65536, 128
        assert Hq % Hkv == 0, (Hq, Hkv)
        return {
            "x": _w((lambda *s: torch.randn(*s, dtype=torch.bfloat16) * 0.05)(B, Sq, D)),
            "k_cache": _w((lambda *s: torch.randn(*s, dtype=torch.bfloat16) * 1.6)(B, Hkv, Sk, Dh)),
            "v_cache": _w((lambda *s: torch.randn(*s, dtype=torch.bfloat16) * 0.8)(B, Hkv, Sk, Dh)),
            "wq": _w((lambda *s: torch.randn(*s, dtype=torch.bfloat16) * 1.6)(D, Hq * Dh) * (D ** -0.5)),
            "wo": _w((lambda *s: torch.randn(*s, dtype=torch.bfloat16) * 0.8)(Hq * Dh, D) * ((Hq * Dh) ** -0.5)),
        }
    _A_in = _A_setup()

    def _B_setup():
        B, S, D, F = 1, 1, 1024, 3584
        return {
            "x": _w((lambda *s: torch.randn(*s, dtype=torch.bfloat16) * 0.05)(B, S, D)),
            "W_gate": _w((lambda *s: torch.randn(*s, dtype=torch.bfloat16) * 0.4)(D, F) * (2.0 / D) ** 0.5),
            "W_up": _w((lambda *s: torch.randn(*s, dtype=torch.bfloat16) * 0.4)(D, F) * (2.0 / D) ** 0.5),
            "W_down": _w((lambda *s: torch.randn(*s, dtype=torch.bfloat16) * 0.4)(F, D) * (1.0 / F) ** 0.5),
        }
    _B_in = _B_setup()

    return {
        "A_x": _A_in["x"],
        "A_k_cache": _A_in["k_cache"],
        "A_v_cache": _A_in["v_cache"],
        "A_wq": _A_in["wq"],
        "A_wo": _A_in["wo"],
        "B_x": _B_in["x"],
        "B_W_gate": _B_in["W_gate"],
        "B_W_up": _B_in["W_up"],
        "B_W_down": _B_in["W_down"],
    }

def reference(A_x, A_k_cache, A_v_cache, A_wq, A_wo, B_x, B_W_gate, B_W_up, B_W_down):
    def _A_ref(x, k_cache, v_cache, wq, wo):
        B, Sq, D = x.shape
        Hq, Dh = 32, 128
        Hkv, Sk = k_cache.shape[1], k_cache.shape[2]
        W = min(4096, max(256, Sk // 4))
        rep = Hq // Hkv
        q = (lambda x, *d: x.permute(*d))((x @ wq).reshape(B, Sq, Hq, Dh), 0, 2, 1, 3)
        k = (lambda x, n, axis: torch.repeat_interleave(x, n, dim=axis))(k_cache[:, :, Sk - W:, :], rep, axis=1)
        v = (lambda x, n, axis: torch.repeat_interleave(x, n, dim=axis))(v_cache[:, :, Sk - W:, :], rep, axis=1)
        scores = torch.einsum("bhqd,bhkd->bhqk", q, k) * (Dh ** -0.5)
        p = _softmax(scores, axis=-1)
        o = torch.einsum("bhqk,bhkd->bhqd", p, v)
        return (lambda x, *d: x.permute(*d))(o, 0, 2, 1, 3).reshape(B, Sq, Hq * Dh) @ wo

    def _B_ref(x, W_gate, W_up, W_down):
        gate = torch.einsum("bsd,df->bsf", x, W_gate)
        up = torch.einsum("bsd,df->bsf", x, W_up)
        gate = gate * (lambda x, dt: x.to(dt))(gate > 0, gate.dtype)
        h = gate * up
        return torch.einsum("bsf,fd->bsd", h, W_down)

    x = A_x
    h = x + _A_ref(_layernorm(x, axis=-1), A_k_cache, A_v_cache, A_wq, A_wo)
    h2 = h + _B_ref(_layernorm(h, axis=-1), B_W_gate, B_W_up, B_W_down)
    return h2
```

```asm
; @launch grid=(256,1,1) block=(512,1,1) lds=46848
.amdgcn_target "amdgcn-amd-amdhsa--gfx950"
.text
.globl sequential_preLN__sliding_block_cached__glu_gated_reglu__decode_kernel
.p2align 8
.type sequential_preLN__sliding_block_cached__glu_gated_reglu__decode_kernel,@function
sequential_preLN__sliding_block_cached__glu_gated_reglu__decode_kernel:
    s_cmp_ge_u32 s2, 256
    s_cbranch_scc1 L_end
    s_load_dwordx16 s[4:19], s[0:1], 0
    s_load_dwordx8 s[20:27], s[0:1], 64
    v_lshrrev_b32 v1, 6, v0
    v_and_b32 v0, 63, v0
    v_readfirstlane_b32 s32, v1
    s_and_b32 s34, s2, 63
    s_lshr_b32 s35, s2, 6
    s_lshl_b32 s38, s35, 8
    s_lshl_b32 s39, s32, 5
    s_add_u32 s36, s38, s39
    v_lshlrev_b32 v4, 5, v0
    v_lshrrev_b32 v5, 3, v0
    s_lshl_b32 s38, s36, 1
    v_lshl_add_u32 v6, v5, 3, s38
    v_lshlrev_b32 v5, 15, v5
    v_and_b32 v7, 7, v0
    v_lshl_add_u32 v5, v7, 4, v5
    s_lshl_b32 s38, s36, 13
    s_lshl_b32 s39, s34, 7
    s_add_u32 s37, s38, s39
    s_lshr_b32 s38, s2, 4
    s_lshl_b32 s38, s38, 3
    s_and_b32 s39, s2, 7
    s_or_b32 s33, s38, s39
    s_waitcnt lgkmcnt(0)
    s_add_u32 s40, s10, s37
    s_addc_u32 s41, s11, 0
    global_load_dwordx4 v[64:67], v4, s[4:5]
    global_load_dwordx4 v[68:71], v4, s[4:5] offset:16
    global_load_dwordx2 v[88:89], v6, s[4:5]
    global_load_dwordx4 v[32:35], v5, s[40:41] nt
    s_add_u32 s40, s40, 8192
    s_addc_u32 s41, s41, 0
    global_load_dwordx4 v[36:39], v5, s[40:41] nt
    s_add_u32 s40, s40, 8192
    s_addc_u32 s41, s41, 0
    global_load_dwordx4 v[40:43], v5, s[40:41] nt
    s_add_u32 s40, s40, 8192
    s_addc_u32 s41, s41, 0
    global_load_dwordx4 v[44:47], v5, s[40:41] nt
    s_load_dword s98, s[26:27], 0
    s_and_b32 s38, s33, 7
    s_lshr_b32 s38, s38, 1
    s_lshl_b32 s37, s38, 24
    s_lshr_b32 s38, s33, 3
    s_lshl_b32 s38, s38, 1
    s_and_b32 s39, s33, 1
    s_or_b32 s38, s38, s39
    s_lshl_b32 s38, s38, 15
    s_add_u32 s37, s37, s38
    s_lshl_b32 s39, s32, 12
    s_add_u32 s37, s37, s39
    s_add_u32 s37, s37, 15728640
    s_add_u32 s48, s6, s37
    s_addc_u32 s49, s7, 0
    s_add_u32 s50, s8, s37
    s_addc_u32 s51, s9, 0
    v_and_b32 v4, 7, v0
    v_lshlrev_b32 v4, 8, v4
    v_and_b32 v7, 8, v0
    v_lshl_add_u32 v4, v7, 3, v4
    v_lshrrev_b32 v7, 4, v0
    v_lshl_add_u32 v4, v7, 4, v4
    v_lshlrev_b32 v26, 1, v7
    v_and_b32 v27, 15, v0
    v_xor_b32 v26, v26, v27
    v_lshlrev_b32 v26, 4, v26
    v_lshl_add_u32 v26, v7, 8, v26
    v_xor_b32 v27, 0x80, v26
    s_lshl_b32 s38, s32, 12
    s_add_u32 s38, s38, 0
    s_mov_b32 m0, s38
    s_bitcmp1_b32 s2, 3
    s_cbranch_scc0 L_noK
    global_load_dwordx4 v[48:51], v4, s[48:49] offset:0 nt
    global_load_dwordx4 v[52:55], v4, s[48:49] offset:128 nt
L_noK:
    s_mov_b32 s52, 0x0c0c0400
    s_mov_b32 s53, 0x04000c0c
    s_mov_b32 s54, 0xffffff00
    s_mov_b32 s56, 0xaaaaaaaa
    s_mov_b32 s57, 0xaaaaaaaa
    s_mov_b32 s58, 0xcccccccc
    s_mov_b32 s59, 0xcccccccc
    s_mov_b32 s60, 0xffffffff
    s_mov_b32 s61, 0x0
    s_mov_b32 s62, 0x11111111
    s_mov_b32 s63, 0x11111111
    s_mov_b32 s14, 0xff00ff
    s_mov_b32 s15, 0xff00ff
    s_mov_b32 s0, 0xff
    s_mov_b32 s1, 0x0
    s_mov_b32 s100, 0x10001
    s_mov_b32 s101, 0x10001
    s_mov_b32 s96, 0x3fb8aa3b
    s_mov_b32 s97, 0x3db504f3
    v_mov_b32 v2, 0xff
    v_and_b32 v1, 1, v0
    v_lshlrev_b32 v1, 4, v1
    v_mov_b32 v124, 0xffff
    v_lshlrev_b32 v124, v1, v124
    v_bfe_u32 v1, v0, 1, 2
    v_cmp_eq_u32 vcc, 0, v1
    s_nop 1
    v_cndmask_b32 v112, 0, v124, vcc
    v_cmp_eq_u32 vcc, 1, v1
    s_nop 1
    v_cndmask_b32 v113, 0, v124, vcc
    v_cmp_eq_u32 vcc, 2, v1
    s_nop 1
    v_cndmask_b32 v114, 0, v124, vcc
    v_cmp_eq_u32 vcc, 3, v1
    s_nop 1
    v_cndmask_b32 v115, 0, v124, vcc
    s_lshl_b32 s38, s32, 8
    s_add_u32 s38, s38, 42240
    v_and_b32 v24, 7, v0
    v_lshlrev_b32 v24, 2, v24
    v_and_b32 v25, 16, v0
    v_lshl_add_u32 v24, v25, 3, v24
    v_and_b32 v25, 32, v0
    v_add3_u32 v24, v24, v25, s38
    v_and_b32 v25, 8, v0
    v_cmp_ne_u32 vcc, 0, v25
    v_mov_b32 v25, 46336
    s_nop 0
    v_cndmask_b32 v24, v24, v25, vcc
    s_lshr_b32 s38, s34, 4
    s_lshl_b32 s38, s38, 14
    s_lshl_b32 s39, s35, 12
    s_add_u32 s38, s38, s39
    s_and_b32 s39, s34, 15
    s_lshl_b32 s39, s39, 8
    s_add_u32 s38, s38, s39
    s_add_u32 s42, s26, s38
    s_addc_u32 s43, s27, 0
    s_add_u32 s42, s42, 4096
    s_addc_u32 s43, s43, 0
    v_lshlrev_b32 v6, 2, v0
    s_bitcmp1_b32 s2, 3
    s_cbranch_scc1 L_wx_P
    s_waitcnt vmcnt(4)
    s_branch L_wx
L_wx_P:
    s_waitcnt vmcnt(6)
L_wx:
    v_lshlrev_b32 v72, 16, v64
    v_and_b32 v73, 0xffff0000, v64
    v_lshlrev_b32 v74, 16, v65
    v_and_b32 v75, 0xffff0000, v65
    v_lshlrev_b32 v76, 16, v66
    v_and_b32 v77, 0xffff0000, v66
    v_lshlrev_b32 v78, 16, v67
    v_and_b32 v79, 0xffff0000, v67
    v_lshlrev_b32 v80, 16, v68
    v_and_b32 v81, 0xffff0000, v68
    v_lshlrev_b32 v82, 16, v69
    v_and_b32 v83, 0xffff0000, v69
    v_lshlrev_b32 v84, 16, v70
    v_and_b32 v85, 0xffff0000, v70
    v_lshlrev_b32 v86, 16, v71
    v_and_b32 v87, 0xffff0000, v71
    v_add_f32 v8, v72, v73
    v_add_f32 v11, v74, v75
    v_add_f32 v8, v8, v76
    v_add_f32 v11, v11, v77
    v_add_f32 v8, v8, v78
    v_add_f32 v11, v11, v79
    v_add_f32 v8, v8, v80
    v_add_f32 v11, v11, v81
    v_add_f32 v8, v8, v82
    v_add_f32 v11, v11, v83
    v_add_f32 v8, v8, v84
    v_add_f32 v11, v11, v85
    v_add_f32 v8, v8, v86
    v_add_f32 v11, v11, v87
    v_add_f32 v8, v8, v11
    s_nop 1
    v_add_f32_dpp v8, v8, v8 quad_perm:[1,0,3,2] row_mask:0xf bank_mask:0xf
    s_nop 1
    v_add_f32_dpp v8, v8, v8 quad_perm:[2,3,0,1] row_mask:0xf bank_mask:0xf
    s_nop 1
    v_add_f32_dpp v8, v8, v8 row_ror:4 row_mask:0xf bank_mask:0xf
    s_nop 1
    v_add_f32_dpp v8, v8, v8 row_ror:8 row_mask:0xf bank_mask:0xf
    v_mov_b32 v10, v8
    s_nop 1
    v_permlane16_swap_b32 v10, v8
    v_add_f32 v8, v8, v10
    v_mov_b32 v10, v8
    s_nop 1
    v_permlane32_swap_b32 v10, v8
    v_add_f32 v8, v8, v10
    v_mul_f32 v8, 0x3a800000, v8
    v_sub_f32 v72, v72, v8
    v_sub_f32 v73, v73, v8
    v_sub_f32 v74, v74, v8
    v_sub_f32 v75, v75, v8
    v_sub_f32 v76, v76, v8
    v_sub_f32 v77, v77, v8
    v_sub_f32 v78, v78, v8
    v_sub_f32 v79, v79, v8
    v_sub_f32 v80, v80, v8
    v_sub_f32 v81, v81, v8
    v_sub_f32 v82, v82, v8
    v_sub_f32 v83, v83, v8
    v_sub_f32 v84, v84, v8
    v_sub_f32 v85, v85, v8
    v_sub_f32 v86, v86, v8
    v_sub_f32 v87, v87, v8
    v_mul_f32 v11, v72, v72
    v_mul_f32 v12, v73, v73
    v_fmac_f32 v11, v74, v74
    v_fmac_f32 v12, v75, v75
    v_fmac_f32 v11, v76, v76
    v_fmac_f32 v12, v77, v77
    v_fmac_f32 v11, v78, v78
    v_fmac_f32 v12, v79, v79
    v_fmac_f32 v11, v80, v80
    v_fmac_f32 v12, v81, v81
    v_fmac_f32 v11, v82, v82
    v_fmac_f32 v12, v83, v83
    v_fmac_f32 v11, v84, v84
    v_fmac_f32 v12, v85, v85
    v_fmac_f32 v11, v86, v86
    v_fmac_f32 v12, v87, v87
    v_add_f32 v11, v11, v12
    s_nop 1
    v_add_f32_dpp v11, v11, v11 quad_perm:[1,0,3,2] row_mask:0xf bank_mask:0xf
    s_nop 1
    v_add_f32_dpp v11, v11, v11 quad_perm:[2,3,0,1] row_mask:0xf bank_mask:0xf
    s_nop 1
    v_add_f32_dpp v11, v11, v11 row_ror:4 row_mask:0xf bank_mask:0xf
    s_nop 1
    v_add_f32_dpp v11, v11, v11 row_ror:8 row_mask:0xf bank_mask:0xf
    v_mov_b32 v10, v11
    s_nop 1
    v_permlane16_swap_b32 v10, v11
    v_add_f32 v11, v11, v10
    v_mov_b32 v10, v11
    s_nop 1
    v_permlane32_swap_b32 v10, v11
    v_add_f32 v11, v11, v10
    v_mul_f32 v11, 0x3a800000, v11
    v_cvt_pk_bf16_f32 v10, v11, v11
    v_lshlrev_b32 v11, 16, v10
    v_add_f32 v11, 0x3727c5ac, v11
    v_cvt_pk_bf16_f32 v10, v11, v11
    v_lshlrev_b32 v11, 16, v10
    v_sqrt_f32 v11, v11
    v_cvt_pk_bf16_f32 v10, v8, v8
    v_lshlrev_b32 v8, 16, v10
    v_cvt_pk_bf16_f32 v10, v11, v11
    v_lshlrev_b32 v11, 16, v10
    v_rcp_f32 v9, v11
    v_lshlrev_b32 v72, 16, v88
    v_and_b32 v73, 0xffff0000, v88
    v_lshlrev_b32 v74, 16, v89
    v_and_b32 v75, 0xffff0000, v89
    v_sub_f32 v72, v72, v8
    v_sub_f32 v73, v73, v8
    v_sub_f32 v74, v74, v8
    v_sub_f32 v75, v75, v8
    v_cvt_pk_bf16_f32 v10, v72, v73
    v_cvt_pk_bf16_f32 v11, v74, v75
    v_lshlrev_b32 v72, 16, v10
    v_and_b32 v73, 0xffff0000, v10
    v_lshlrev_b32 v74, 16, v11
    v_and_b32 v75, 0xffff0000, v11
    v_mul_f32 v72, v72, v9
    v_mul_f32 v73, v73, v9
    v_mul_f32 v74, v74, v9
    v_mul_f32 v75, v75, v9
    v_cvt_pk_bf16_f32 v104, v72, v72
    v_cvt_pk_bf16_f32 v105, v73, v73
    v_cvt_pk_bf16_f32 v106, v74, v74
    v_cvt_pk_bf16_f32 v107, v75, v75
    s_waitcnt lgkmcnt(0)
    s_add_u32 s98, s98, 1
    s_mul_i32 s28, s98, 0x01010101
    s_lshr_b32 s29, s28, 8
    s_lshr_b32 s30, s28, 16
    s_lshr_b32 s31, s28, 24
    v_and_b32 v1, 3, v0
    v_lshlrev_b32 v1, 3, v1
    v_lshrrev_b32 v3, v1, s28
    s_bitcmp1_b32 s2, 3
    s_cbranch_scc1 L_wq_P
    s_waitcnt vmcnt(0)
    s_branch L_wq
L_wq_P:
    s_waitcnt vmcnt(2)
    global_load_dwordx4 v[56:59], v4, s[48:49] offset:2048 nt
    global_load_dwordx4 v[60:63], v4, s[48:49] offset:2176 nt
    global_load_lds_dwordx4 v26, s[50:51] offset:0 nt
    global_load_lds_dwordx4 v26, s[50:51] offset:1024 nt
L_wq:
    v_and_b32 v116, v104, v112
    v_and_b32 v117, v104, v113
    v_and_b32 v118, v104, v114
    v_and_b32 v119, v104, v115
    v_and_b32 v120, v105, v112
    v_and_b32 v121, v105, v113
    v_and_b32 v122, v105, v114
    v_and_b32 v123, v105, v115
    v_mfma_f32_16x16x32_bf16 v[96:99], v[32:35], v[116:119], 0
    v_and_b32 v116, v106, v112
    v_and_b32 v117, v106, v113
    v_and_b32 v118, v106, v114
    v_and_b32 v119, v106, v115
    v_mfma_f32_16x16x32_bf16 v[96:99], v[36:39], v[120:123], v[96:99]
    v_and_b32 v120, v107, v112
    v_and_b32 v121, v107, v113
    v_and_b32 v122, v107, v114
    v_and_b32 v123, v107, v115
    v_mfma_f32_16x16x32_bf16 v[96:99], v[40:43], v[116:119], v[96:99]
    s_nop 0
    v_mfma_f32_16x16x32_bf16 v[96:99], v[44:47], v[120:123], v[96:99]
    s_nop 7
    v_permlane32_swap_b32 v96, v97
    v_permlane32_swap_b32 v98, v99
    s_nop 0
    v_add_f32_dpp v96, v97, v96 row_ror:8 row_mask:0xf bank_mask:0xf
    v_add_f32_dpp v98, v99, v98 row_ror:8 row_mask:0xf bank_mask:0xf
    ds_write_b32 v24, v96
    ds_write_b32 v24, v98 offset:64
    s_waitcnt lgkmcnt(0)
    s_barrier
    s_cmp_lg_u32 s32, 0
    s_cbranch_scc1 L_Q_skip
    ds_read2st64_b32 v[8:9], v6 offset0:165 offset1:166
    ds_read2st64_b32 v[10:11], v6 offset0:167 offset1:168
    ds_read2st64_b32 v[12:13], v6 offset0:169 offset1:170
    ds_read2st64_b32 v[14:15], v6 offset0:171 offset1:172
    s_waitcnt lgkmcnt(0)
    v_add_f32 v8, v8, v12
    v_add_f32 v9, v9, v13
    v_add_f32 v10, v10, v14
    v_add_f32 v11, v11, v15
    v_add_f32 v8, v8, v10
    v_add_f32 v9, v9, v11
    v_add_f32 v8, v8, v9
    v_add_u32 v8, 0x80, v8
    v_bfi_b32 v8, v2, v3, v8
    s_nop 1
    v_mov_b32_dpp v9, v8 quad_perm:[1,1,1,1] row_mask:0xf bank_mask:0xf
    v_mov_b32_dpp v10, v8 quad_perm:[2,2,2,2] row_mask:0xf bank_mask:0xf
    v_mov_b32_dpp v11, v8 quad_perm:[3,3,3,3] row_mask:0xf bank_mask:0xf
    s_mov_b64 exec, s[62:63]
    global_store_dwordx4 v6, v[8:11], s[42:43] sc1
    s_mov_b64 exec, -1
L_Q_skip:
    s_bitcmp1_b32 s2, 3
    s_cbranch_scc1 L_P
    s_and_b32 s38, s33, 7
    s_lshl_b32 s38, s38, 2
    s_lshr_b32 s39, s33, 5
    s_add_u32 s34, s38, s39
    s_bfe_u32 s35, s33, 0x20003
    s_lshl_b32 s38, s34, 7
    s_lshl_b32 s39, s32, 4
    s_add_u32 s38, s38, s39
    s_lshl_b32 s38, s38, 11
    s_lshl_b32 s39, s35, 9
    s_add_u32 s38, s38, s39
    s_add_u32 s40, s12, s38
    s_addc_u32 s41, s13, 0
    s_add_u32 s40, s40, 4096
    s_addc_u32 s41, s41, 0
    v_lshrrev_b32 v4, 5, v0
    v_lshlrev_b32 v4, 14, v4
    v_and_b32 v5, 31, v0
    v_lshl_add_u32 v4, v5, 4, v4
    s_barrier
    global_load_dwordx4 v[32:35], v4, s[40:41] offset:-4096 nt
    global_load_dwordx4 v[36:39], v4, s[40:41] offset:-2048 nt
    s_waitcnt vmcnt(1)
    global_load_dwordx4 v[40:43], v4, s[40:41] offset:0 nt
    s_waitcnt vmcnt(1)
    global_load_dwordx4 v[44:47], v4, s[40:41] offset:2048 nt
    s_add_u32 s40, s40, 8192
    s_addc_u32 s41, s41, 0
    s_waitcnt vmcnt(1)
    global_load_dwordx4 v[48:51], v4, s[40:41] offset:-4096 nt
    s_waitcnt vmcnt(1)
    global_load_dwordx4 v[52:55], v4, s[40:41] offset:-2048 nt
    s_waitcnt vmcnt(1)
    global_load_dwordx4 v[56:59], v4, s[40:41] offset:0 nt
    s_waitcnt vmcnt(1)
    global_load_dwordx4 v[60:63], v4, s[40:41] offset:2048 nt
    s_lshl_b32 s38, s34, 14
    s_lshl_b32 s39, s32, 6
    s_add_u32 s38, s38, s39
    s_add_u32 s44, s26, s38
    s_addc_u32 s45, s27, 0
    s_add_u32 s44, s44, 131072
    s_addc_u32 s45, s45, 0
    s_lshr_b32 s38, s34, 3
    s_lshl_b32 s38, s38, 12
    s_and_b32 s39, s34, 7
    s_lshl_b32 s39, s39, 4
    s_add_u32 s38, s38, s39
    s_add_u32 s46, s26, s38
    s_addc_u32 s47, s27, 0
    s_add_u32 s46, s46, 655360
    s_addc_u32 s47, s47, 0
    v_lshrrev_b32 v5, 2, v0
    v_and_b32 v6, 3, v0
    v_lshlrev_b32 v6, 4, v6
    v_lshl_add_u32 v6, v5, 9, v6
    v_add_u32 v7, 0x2000, v6
    v_lshlrev_b32 v5, 7, v5
    v_lshrrev_b32 v1, 1, v0
    v_xor_b32 v1, v1, v0
    v_and_b32 v1, 8, v1
    v_cmp_eq_u32 vcc, 0, v1
    s_nop 1
    v_cndmask_b32 v64, 0, v112, vcc
    v_cndmask_b32 v65, 0, v113, vcc
    v_cndmask_b32 v66, 0, v114, vcc
    v_cndmask_b32 v67, 0, v115, vcc
    s_lshl_b32 s38, s32, 8
    s_add_u32 s38, s38, 44288
    v_and_b32 v28, 3, v0
    v_lshlrev_b32 v28, 4, v28
    v_lshrrev_b32 v29, 4, v0
    v_lshlrev_b32 v29, 2, v29
    v_add3_u32 v28, v28, v29, s38
    v_lshrrev_b32 v29, 5, v0
    v_lshl_add_u32 v29, v29, 5, s38
    v_and_b32 v30, 7, v0
    v_lshlrev_b32 v30, 2, v30
    v_and_b32 v31, 8, v0
    v_lshl_add_u32 v30, v31, 6, v30
    v_lshrrev_b32 v31, 4, v0
    v_lshl_add_u32 v30, v31, 7, v30
    s_lshl_b32 s38, s32, 10
    v_add_u32 v30, s38, v30
    s_lshl_b32 s38, s35, 5
    s_add_u32 s38, s38, s34
    s_lshl_b32 s38, s38, 10
    s_add_u32 s42, s26, s38
    s_addc_u32 s43, s27, 0
    s_add_u32 s42, s42, 720896
    s_addc_u32 s43, s43, 0
    s_lshl_b32 s38, s32, 8
    v_lshl_add_u32 v31, v0, 2, s38
    s_and_b32 s36, s33, 7
    s_lshr_b32 s37, s33, 3
    s_min_u32 s38, s36, 6
    s_lshl_b32 s38, s38, 9
    s_lshl_b32 s39, s32, 6
    s_add_u32 s38, s38, s39
    s_lshl_b32 s38, s38, 11
    s_lshl_b32 s39, s37, 7
    s_add_u32 s38, s38, s39
    s_add_u32 s48, s20, s38
    s_addc_u32 s49, s21, 0
    s_add_u32 s48, s48, 4096
    s_addc_u32 s49, s49, 0
    v_and_b32 v27, 0x38, v0
    v_lshlrev_b32 v27, 11, v27
    v_and_b32 v1, 7, v0
    v_lshl_add_u32 v27, v1, 4, v27
    s_waitcnt vmcnt(2)
    v_lshrrev_b32 v25, 2, v0
    v_lshlrev_b32 v25, 2, v25
    s_cmp_lg_u32 s32, 0
    s_cbranch_scc1 L_o1w
    s_mov_b32 s55, 400000
L_lp_1:
    global_load_dwordx4 v[16:19], v5, s[46:47] sc1
    global_load_dwordx4 v[20:23], v5, s[46:47] offset:2048 sc1
    s_waitcnt vmcnt(0)
    v_perm_b32 v68, v17, v16, s52
    v_perm_b32 v69, v19, v18, s53
    v_or_b32 v70, v68, v69
    v_perm_b32 v68, v21, v20, s52
    v_perm_b32 v69, v23, v22, s53
    v_or_b32 v68, v68, v69
    v_xor_b32 v68, v68, v70
    v_mov_b32 v71, v68
    v_xor_b32 v70, s28, v70
    v_or_b32 v70, v70, v71
    v_cmp_ne_u32 vcc, 0, v70
    s_bcnt1_i32_b64 s39, vcc
    s_cmp_le_u32 s39, 0
    s_cbranch_scc1 L_lpx_2
    s_sleep 2
    s_sub_u32 s55, s55, 1
    s_cmp_lg_u32 s55, 0
    s_cbranch_scc1 L_lp_1
L_lpx_2:
L_o1w:
    s_barrier
    global_load_dwordx4 v[8:11], v6, s[44:45] sc1
    global_load_dwordx4 v[12:15], v7, s[44:45] sc1
    s_cmp_lg_u32 s32, 0
    s_cbranch_scc1 L_ow_skip
    v_and_b32 v16, s54, v16
    v_and_b32 v20, s54, v20
    v_and_b32 v17, s54, v17
    v_and_b32 v21, s54, v21
    v_max_f32 v24, v16, v20
    s_nop 1
    v_max_f32_dpp v24, v24, v24 row_ror:4 row_mask:0xf bank_mask:0xf
    s_nop 1
    v_max_f32_dpp v24, v24, v24 row_ror:8 row_mask:0xf bank_mask:0xf
    v_mov_b32 v26, v24
    s_nop 1
    v_permlane16_swap_b32 v26, v24
    v_max_f32 v24, v24, v26
    v_mov_b32 v26, v24
    s_nop 1
    v_permlane32_swap_b32 v26, v24
    v_max_f32 v24, v24, v26
    v_sub_f32 v16, v16, v24
    v_sub_f32 v20, v20, v24
    v_mul_f32 v16, s96, v16
    v_mul_f32 v20, s96, v20
    v_exp_f32 v16, v16
    v_exp_f32 v20, v20
    v_mul_f32 v24, v16, v17
    v_fmac_f32 v24, v20, v21
    s_nop 1
    v_add_f32_dpp v24, v24, v24 row_ror:4 row_mask:0xf bank_mask:0xf
    s_nop 1
    v_add_f32_dpp v24, v24, v24 row_ror:8 row_mask:0xf bank_mask:0xf
    v_mov_b32 v26, v24
    s_nop 1
    v_permlane16_swap_b32 v26, v24
    v_add_f32 v24, v24, v26
    v_mov_b32 v26, v24
    s_nop 1
    v_permlane32_swap_b32 v26, v24
    v_add_f32 v24, v24, v26
    v_rcp_f32 v24, v24
    s_nop 0
    v_mul_f32 v16, v16, v24
    v_mul_f32 v20, v20, v24
    ds_write_b32 v25, v16 offset:37632
    ds_write_b32 v25, v20 offset:37696
    s_waitcnt lgkmcnt(0)
L_ow_skip:
    s_barrier
    ds_read_b32 v16, v25 offset:37632
    ds_read_b32 v20, v25 offset:37696
    s_waitcnt vmcnt(0)
    v_perm_b32 v68, v9, v8, s52
    v_perm_b32 v69, v11, v10, s53
    v_or_b32 v70, v68, v69
    v_perm_b32 v68, v13, v12, s52
    v_perm_b32 v69, v15, v14, s53
    v_or_b32 v68, v68, v69
    v_xor_b32 v68, v68, v70
    v_mov_b32 v71, v68
    v_xor_b32 v70, s28, v70
    v_or_b32 v70, v70, v71
    v_cmp_ne_u32 vcc, 0, v70
    s_cbranch_vccz L_ow_got
    s_mov_b32 s55, 400000
L_poll_3:
    global_load_dwordx4 v[8:11], v6, s[44:45] sc1
    global_load_dwordx4 v[12:15], v7, s[44:45] sc1
    s_waitcnt vmcnt(0)
    v_perm_b32 v68, v9, v8, s52
    v_perm_b32 v69, v11, v10, s53
    v_or_b32 v70, v68, v69
    v_perm_b32 v68, v13, v12, s52
    v_perm_b32 v69, v15, v14, s53
    v_or_b32 v68, v68, v69
    v_xor_b32 v68, v68, v70
    v_mov_b32 v71, v68
    v_xor_b32 v70, s28, v70
    v_or_b32 v70, v70, v71
    v_cmp_ne_u32 vcc, 0, v70
    s_cbranch_vccz L_pollx_4
    s_sleep 2
    s_sub_u32 s55, s55, 1
    s_cmp_lg_u32 s55, 0
    s_cbranch_scc1 L_poll_3
L_pollx_4:
L_ow_got:
    v_and_b32 v8, s54, v8
    v_and_b32 v9, s54, v9
    v_and_b32 v10, s54, v10
    v_and_b32 v11, s54, v11
    v_and_b32 v12, s54, v12
    v_and_b32 v13, s54, v13
    v_and_b32 v14, s54, v14
    v_and_b32 v15, s54, v15
    s_waitcnt lgkmcnt(0)
    v_mul_f32 v8, v8, v16
    v_mul_f32 v9, v9, v16
    v_mul_f32 v10, v10, v16
    v_mul_f32 v11, v11, v16
    v_fmac_f32 v8, v12, v20
    v_fmac_f32 v9, v13, v20
    v_fmac_f32 v10, v14, v20
    v_fmac_f32 v11, v15, v20
    s_nop 0
    v_permlane32_swap_b32 v8, v10
    v_permlane32_swap_b32 v9, v11
    v_add_f32 v8, v8, v10
    v_add_f32 v9, v9, v11
    s_nop 1
    v_permlane16_swap_b32 v8, v9
    v_add_f32 v8, v8, v9
    s_nop 1
    v_add_f32_dpp v8, v8, v8 row_ror:4 row_mask:0xf bank_mask:0xf
    s_nop 1
    v_add_f32_dpp v8, v8, v8 row_ror:8 row_mask:0xf bank_mask:0xf
    v_cvt_pk_bf16_f32 v8, v8, v8
    ds_write_b32 v28, v8
    s_waitcnt lgkmcnt(0)
    ds_read_b128 v[104:107], v29
    ds_read_b128 v[108:111], v29 offset:16
    s_waitcnt lgkmcnt(0)
    v_and_b32 v116, v104, v64
    v_and_b32 v117, v104, v65
    v_and_b32 v118, v104, v66
    v_and_b32 v119, v104, v67
    v_and_b32 v120, v105, v64
    v_and_b32 v121, v105, v65
    v_and_b32 v122, v105, v66
    v_and_b32 v123, v105, v67
    v_mfma_f32_16x16x32_bf16 v[96:99], v[32:35], v[116:119], 0
    v_and_b32 v116, v106, v64
    v_and_b32 v117, v106, v65
    v_and_b32 v118, v106, v66
    v_and_b32 v119, v106, v67
    v_mfma_f32_16x16x32_bf16 v[96:99], v[36:39], v[120:123], v[96:99]
    v_and_b32 v120, v107, v64
    v_and_b32 v121, v107, v65
    v_and_b32 v122, v107, v66
    v_and_b32 v123, v107, v67
    v_mfma_f32_16x16x32_bf16 v[96:99], v[40:43], v[116:119], v[96:99]
    v_and_b32 v116, v108, v64
    v_and_b32 v117, v108, v65
    v_and_b32 v118, v108, v66
    v_and_b32 v119, v108, v67
    v_mfma_f32_16x16x32_bf16 v[96:99], v[44:47], v[120:123], v[96:99]
    v_and_b32 v120, v109, v64
    v_and_b32 v121, v109, v65
    v_and_b32 v122, v109, v66
    v_and_b32 v123, v109, v67
    v_mfma_f32_16x16x32_bf16 v[96:99], v[48:51], v[116:119], v[96:99]
    v_and_b32 v116, v110, v64
    v_and_b32 v117, v110, v65
    v_and_b32 v118, v110, v66
    v_and_b32 v119, v110, v67
    v_mfma_f32_16x16x32_bf16 v[96:99], v[52:55], v[120:123], v[96:99]
    v_and_b32 v120, v111, v64
    v_and_b32 v121, v111, v65
    v_and_b32 v122, v111, v66
    v_and_b32 v123, v111, v67
    v_mfma_f32_16x16x32_bf16 v[96:99], v[56:59], v[116:119], v[96:99]
    s_nop 0
    v_mfma_f32_16x16x32_bf16 v[96:99], v[60:63], v[120:123], v[96:99]
    s_nop 7
    ds_write_b32 v30, v96 offset:0
    ds_write_b32 v30, v97 offset:32
    ds_write_b32 v30, v98 offset:64
    ds_write_b32 v30, v99 offset:96
    s_waitcnt lgkmcnt(0)
    s_barrier
    s_cmp_ge_u32 s32, 4
    s_cbranch_scc1 L_O_skip
    ds_read2st64_b32 v[8:9], v31 offset0:0 offset1:4
    ds_read2st64_b32 v[10:11], v31 offset0:8 offset1:12
    ds_read2st64_b32 v[12:13], v31 offset0:16 offset1:20
    ds_read2st64_b32 v[14:15], v31 offset0:24 offset1:28
    s_waitcnt lgkmcnt(0)
    v_add_f32 v8, v8, v12
    v_add_f32 v9, v9, v13
    v_add_f32 v10, v10, v14
    v_add_f32 v11, v11, v15
    v_add_f32 v8, v8, v10
    v_add_f32 v9, v9, v11
    v_add_f32 v8, v8, v9
    v_add_u32 v8, 0x80, v8
    v_bfi_b32 v8, v2, v3, v8
    s_nop 1
    v_mov_b32_dpp v9, v8 quad_perm:[1,1,1,1] row_mask:0xf bank_mask:0xf
    v_mov_b32_dpp v10, v8 quad_perm:[2,2,2,2] row_mask:0xf bank_mask:0xf
    v_mov_b32_dpp v11, v8 quad_perm:[3,3,3,3] row_mask:0xf bank_mask:0xf
    s_mov_b64 exec, s[62:63]
    global_store_dwordx4 v31, v[8:11], s[42:43] sc1
    s_mov_b64 exec, -1
L_O_skip:
    s_barrier
    s_cmp_eq_u32 s36, 7
    s_cbranch_scc1 L_HF
    global_load_dwordx4 v[32:35], v27, s[48:49] offset:-4096 nt
    global_load_dwordx4 v[36:39], v27, s[48:49] offset:-2048 nt
    s_waitcnt vmcnt(1)
    global_load_dwordx4 v[40:43], v27, s[48:49] offset:0 nt
    s_waitcnt vmcnt(1)
    global_load_dwordx4 v[44:47], v27, s[48:49] offset:2048 nt
    s_add_u32 s48, s48, 8192
    s_addc_u32 s49, s49, 0
    s_waitcnt vmcnt(1)
    global_load_dwordx4 v[48:51], v27, s[48:49] offset:-4096 nt
    s_waitcnt vmcnt(1)
    global_load_dwordx4 v[52:55], v27, s[48:49] offset:-2048 nt
    s_waitcnt vmcnt(1)
    global_load_dwordx4 v[56:59], v27, s[48:49] offset:0 nt
    s_waitcnt vmcnt(1)
    global_load_dwordx4 v[60:63], v27, s[48:49] offset:2048 nt
    s_lshl_b32 s38, s36, 2
    s_lshr_b32 s39, s32, 1
    s_add_u32 s38, s38, s39
    s_lshl_b32 s38, s38, 12
    s_and_b32 s39, s32, 1
    s_lshl_b32 s39, s39, 8
    s_add_u32 s38, s38, s39
    s_add_u32 s44, s26, s38
    s_addc_u32 s45, s27, 0
    s_add_u32 s44, s44, 1114112
    s_addc_u32 s45, s45, 0
    s_add_u32 s46, s26, s38
    s_addc_u32 s47, s27, 0
    s_add_u32 s46, s46, 1245184
    s_addc_u32 s47, s47, 0
    v_and_b32 v5, 1, v0
    v_lshlrev_b32 v5, 10, v5
    v_and_b32 v6, 2, v0
    v_lshl_add_u32 v5, v6, 8, v5
    v_lshrrev_b32 v6, 2, v0
    v_lshl_add_u32 v5, v6, 4, v5
    s_lshl_b32 s38, s32, 8
    s_add_u32 s38, s38, 44288
    v_lshl_add_u32 v28, v6, 4, s38
    v_and_b32 v1, 3, v0
    v_cmp_ne_u32 vcc, 0, v1
    v_mov_b32 v1, 46336
    s_nop 0
    v_cndmask_b32 v28, v28, v1, vcc
    v_and_b32 v29, 0x38, v0
    v_lshl_add_u32 v29, v29, 2, s38
    s_lshl_b32 s38, s32, 8
    s_add_u32 s38, s38, 0
    v_and_b32 v30, 7, v0
    v_lshlrev_b32 v30, 2, v30
    v_and_b32 v31, 16, v0
    v_lshl_add_u32 v30, v31, 3, v30
    v_and_b32 v31, 32, v0
    v_add3_u32 v30, v30, v31, s38
    v_and_b32 v31, 8, v0
    v_cmp_ne_u32 vcc, 0, v31
    v_mov_b32 v31, 46336
    s_nop 0
    v_cndmask_b32 v30, v30, v31, vcc
    s_lshl_b32 s38, s37, 3
    s_add_u32 s38, s38, s36
    s_lshl_b32 s38, s38, 8
    s_add_u32 s42, s26, s38
    s_addc_u32 s43, s27, 0
    s_add_u32 s42, s42, 950272
    s_addc_u32 s43, s43, 0
    v_lshlrev_b32 v31, 2, v0
    s_mov_b64 s[40:41], s[46:47]
    s_waitcnt vmcnt(0)
    s_mov_b32 s55, 400000
L_poll_5:
    global_load_dwordx4 v[8:11], v5, s[40:41] sc1
    global_load_dwordx4 v[12:15], v5, s[40:41] offset:2048 sc1
    s_waitcnt vmcnt(0)
    v_perm_b32 v68, v9, v8, s52
    v_perm_b32 v69, v11, v10, s53
    v_or_b32 v70, v68, v69
    v_perm_b32 v68, v13, v12, s52
    v_perm_b32 v69, v15, v14, s53
    v_or_b32 v68, v68, v69
    v_xor_b32 v68, v68, v70
    v_mov_b32 v71, v68
    v_xor_b32 v70, s28, v70
    v_or_b32 v70, v70, v71
    v_cmp_ne_u32 vcc, 0, v70
    s_cbranch_vccz L_pollx_6
    s_and_b32 s38, s55, 1
    s_cmp_lt_u32 s55, 399988
    s_cselect_b32 s38, s38, 0
    s_cmp_lg_u32 s38, 0
    s_cselect_b64 s[40:41], s[44:45], s[46:47]
    s_sleep 4
    s_sub_u32 s55, s55, 1
    s_cmp_lg_u32 s55, 0
    s_cbranch_scc1 L_poll_5
L_pollx_6:
    v_and_b32 v8, s54, v8
    v_and_b32 v9, s54, v9
    v_and_b32 v10, s54, v10
    v_and_b32 v11, s54, v11
    v_and_b32 v12, s54, v12
    v_and_b32 v13, s54, v13
    v_and_b32 v14, s54, v14
    v_and_b32 v15, s54, v15
    v_add_f32 v8, v8, v12
    v_add_f32 v9, v9, v13
    v_add_f32 v10, v10, v14
    v_add_f32 v11, v11, v15
    v_add_f32_dpp v8, v8, v8 quad_perm:[1,0,3,2] row_mask:0xf bank_mask:0xf
    v_add_f32_dpp v9, v9, v9 quad_perm:[1,0,3,2] row_mask:0xf bank_mask:0xf
    v_add_f32_dpp v10, v10, v10 quad_perm:[1,0,3,2] row_mask:0xf bank_mask:0xf
    v_add_f32_dpp v11, v11, v11 quad_perm:[1,0,3,2] row_mask:0xf bank_mask:0xf
    v_cvt_pk_bf16_f32 v24, v8, v9
    v_cvt_pk_bf16_f32 v25, v10, v11
    v_lshlrev_b32 v8, 16, v24
    v_and_b32 v9, 0xffff0000, v24
    v_lshlrev_b32 v10, 16, v25
    v_and_b32 v11, 0xffff0000, v25
    v_mov_b32_dpp v12, v8 quad_perm:[2,3,0,1] row_mask:0xf bank_mask:0xf
    v_mov_b32_dpp v13, v9 quad_perm:[2,3,0,1] row_mask:0xf bank_mask:0xf
    v_mov_b32_dpp v14, v10 quad_perm:[2,3,0,1] row_mask:0xf bank_mask:0xf
    v_mov_b32_dpp v15, v11 quad_perm:[2,3,0,1] row_mask:0xf bank_mask:0xf
    v_max_f32 v8, 0, v8
    v_max_f32 v9, 0, v9
    v_max_f32 v10, 0, v10
    v_max_f32 v11, 0, v11
    v_mul_f32 v8, v8, v12
    v_mul_f32 v9, v9, v13
    v_mul_f32 v10, v10, v14
    v_mul_f32 v11, v11, v15
    v_cvt_pk_bf16_f32 v16, v8, v8
    v_cvt_pk_bf16_f32 v17, v9, v9
    v_cvt_pk_bf16_f32 v18, v10, v10
    v_cvt_pk_bf16_f32 v19, v11, v11
    ds_write_b128 v28, v[16:19]
    s_waitcnt lgkmcnt(0)
    ds_read_b128 v[104:107], v29
    ds_read_b128 v[108:111], v29 offset:16
    s_waitcnt lgkmcnt(0)
    v_and_b32 v116, v104, v112
    v_and_b32 v117, v104, v113
    v_and_b32 v118, v104, v114
    v_and_b32 v119, v104, v115
    v_and_b32 v120, v105, v112
    v_and_b32 v121, v105, v113
    v_and_b32 v122, v105, v114
    v_and_b32 v123, v105, v115
    v_mfma_f32_16x16x32_bf16 v[96:99], v[32:35], v[116:119], 0
    v_and_b32 v116, v106, v112
    v_and_b32 v117, v106, v113
    v_and_b32 v118, v106, v114
    v_and_b32 v119, v106, v115
    v_mfma_f32_16x16x32_bf16 v[96:99], v[36:39], v[120:123], v[96:99]
    v_and_b32 v120, v107, v112
    v_and_b32 v121, v107, v113
    v_and_b32 v122, v107, v114
    v_and_b32 v123, v107, v115
    v_mfma_f32_16x16x32_bf16 v[96:99], v[40:43], v[116:119], v[96:99]
    v_and_b32 v116, v108, v112
    v_and_b32 v117, v108, v113
    v_and_b32 v118, v108, v114
    v_and_b32 v119, v108, v115
    v_mfma_f32_16x16x32_bf16 v[96:99], v[44:47], v[120:123], v[96:99]
    v_and_b32 v120, v109, v112
    v_and_b32 v121, v109, v113
    v_and_b32 v122, v109, v114
    v_and_b32 v123, v109, v115
    v_mfma_f32_16x16x32_bf16 v[96:99], v[48:51], v[116:119], v[96:99]
    v_and_b32 v116, v110, v112
    v_and_b32 v117, v110, v113
    v_and_b32 v118, v110, v114
    v_and_b32 v119, v110, v115
    v_mfma_f32_16x16x32_bf16 v[96:99], v[52:55], v[120:123], v[96:99]
    v_and_b32 v120, v111, v112
    v_and_b32 v121, v111, v113
    v_and_b32 v122, v111, v114
    v_and_b32 v123, v111, v115
    v_mfma_f32_16x16x32_bf16 v[96:99], v[56:59], v[116:119], v[96:99]
    s_nop 0
    v_mfma_f32_16x16x32_bf16 v[96:99], v[60:63], v[120:123], v[96:99]
    s_nop 7
    v_permlane32_swap_b32 v96, v97
    v_permlane32_swap_b32 v98, v99
    s_nop 0
    v_add_f32_dpp v96, v97, v96 row_ror:8 row_mask:0xf bank_mask:0xf
    v_add_f32_dpp v98, v99, v98 row_ror:8 row_mask:0xf bank_mask:0xf
    ds_write_b32 v30, v96
    ds_write_b32 v30, v98 offset:64
    s_waitcnt lgkmcnt(0)
    s_barrier
    s_cmp_lg_u32 s32, 0
    s_cbranch_scc1 L_D_done
    ds_read2st64_b32 v[8:9], v31 offset0:0 offset1:1
    ds_read2st64_b32 v[10:11], v31 offset0:2 offset1:3
    ds_read2st64_b32 v[12:13], v31 offset0:4 offset1:5
    ds_read2st64_b32 v[14:15], v31 offset0:6 offset1:7
    s_waitcnt lgkmcnt(0)
    v_add_f32 v8, v8, v12
    v_add_f32 v9, v9, v13
    v_add_f32 v10, v10, v14
    v_add_f32 v11, v11, v15
    v_add_f32 v8, v8, v10
    v_add_f32 v9, v9, v11
    v_add_f32 v8, v8, v9
    v_add_u32 v8, 0x80, v8
    v_bfi_b32 v8, v2, v3, v8
    s_nop 1
    v_mov_b32_dpp v9, v8 quad_perm:[1,1,1,1] row_mask:0xf bank_mask:0xf
    v_mov_b32_dpp v10, v8 quad_perm:[2,2,2,2] row_mask:0xf bank_mask:0xf
    v_mov_b32_dpp v11, v8 quad_perm:[3,3,3,3] row_mask:0xf bank_mask:0xf
    s_mov_b64 exec, s[62:63]
    global_store_dwordx4 v31, v[8:11], s[42:43] sc1
    s_mov_b64 exec, -1
L_D_done:
    s_endpgm
L_HF:
    s_lshl_b32 s38, s37, 3
    s_add_u32 s34, s38, s32
    s_lshr_b32 s38, s34, 5
    s_lshl_b32 s38, s38, 15
    s_and_b32 s39, s34, 31
    s_lshl_b32 s39, s39, 5
    s_add_u32 s38, s38, s39
    s_add_u32 s40, s26, s38
    s_addc_u32 s41, s27, 0
    s_add_u32 s40, s40, 720896
    s_addc_u32 s41, s41, 0
    s_add_u32 s44, s26, 851968
    s_addc_u32 s45, s27, 0
    v_and_b32 v4, 31, v0
    v_lshlrev_b32 v4, 10, v4
    v_lshrrev_b32 v5, 5, v0
    v_lshl_add_u32 v4, v5, 4, v4
    v_and_b32 v7, 3, v0
    v_lshl_add_u32 v7, v5, 2, v7
    s_lshl_b32 s38, s34, 3
    v_add_u32 v7, s38, v7
    v_lshlrev_b32 v24, 1, v7
    global_load_ushort v25, v24, s[4:5]
    v_and_b32 v26, 7, v7
    v_lshlrev_b32 v26, 2, v26
    v_lshrrev_b32 v7, 3, v7
    v_lshl_add_u32 v7, v7, 5, v26
    s_mov_b32 s48, 0x1
    s_mov_b32 s49, 0x1
    s_mov_b32 s55, 400000
L_poll_7:
    global_load_dwordx4 v[8:11], v4, s[40:41] sc1
    s_waitcnt vmcnt(0)
    v_perm_b32 v68, v9, v8, s52
    v_perm_b32 v69, v11, v10, s53
    v_or_b32 v70, v68, v69
    v_xor_b32 v70, s28, v70
    v_cmp_ne_u32 vcc, 0, v70
    s_cbranch_vccz L_pollx_8
    s_sleep 2
    s_sub_u32 s55, s55, 1
    s_cmp_lg_u32 s55, 0
    s_cbranch_scc1 L_poll_7
L_pollx_8:
    v_and_b32 v8, s54, v8
    v_and_b32 v9, s54, v9
    v_and_b32 v10, s54, v10
    v_and_b32 v11, s54, v11
    v_cndmask_b32 v12, v8, v10, s[58:59]
    v_cndmask_b32 v14, v10, v8, s[58:59]
    v_cndmask_b32 v13, v9, v11, s[58:59]
    v_cndmask_b32 v15, v11, v9, s[58:59]
    v_add_f32_dpp v8, v14, v12 quad_perm:[2,3,0,1] row_mask:0xf bank_mask:0xf
    s_nop 0
    v_add_f32_dpp v9, v15, v13 quad_perm:[2,3,0,1] row_mask:0xf bank_mask:0xf
    v_cndmask_b32 v12, v8, v9, s[56:57]
    v_cndmask_b32 v13, v9, v8, s[56:57]
    s_nop 1
    v_add_f32_dpp v8, v13, v12 quad_perm:[1,0,3,2] row_mask:0xf bank_mask:0xf
    v_lshlrev_b32 v25, 16, v25
    s_nop 0
    v_add_f32_dpp v8, v8, v8 row_ror:4 row_mask:0xf bank_mask:0xf
    s_nop 1
    v_add_f32_dpp v8, v8, v8 row_ror:8 row_mask:0xf bank_mask:0xf
    v_mov_b32 v68, v8
    s_nop 1
    v_permlane16_swap_b32 v68, v8
    v_add_f32 v8, v8, v68
    v_cvt_pk_bf16_f32 v68, v8, v8
    v_lshlrev_b32 v8, 16, v68
    v_add_f32 v8, v8, v25
    v_cvt_pk_bf16_f32 v68, v8, v8
    v_lshlrev_b32 v8, 16, v68
    v_bfi_b32 v8, v2, v3, v8
    s_nop 1
    v_mov_b32_dpp v9, v8 quad_perm:[1,1,1,1] row_mask:0xf bank_mask:0xf
    v_mov_b32_dpp v10, v8 quad_perm:[2,2,2,2] row_mask:0xf bank_mask:0xf
    v_mov_b32_dpp v11, v8 quad_perm:[3,3,3,3] row_mask:0xf bank_mask:0xf
    s_mov_b64 exec, s[48:49]
    global_store_dwordx4 v7, v[8:11], s[44:45] sc1
    s_mov_b64 exec, -1
    s_cmp_lg_u32 s32, 0
    s_cbranch_scc1 L_HF_done
L_F:
    s_lshl_b32 s38, s37, 11
    s_add_u32 s40, s26, s38
    s_addc_u32 s41, s27, 0
    s_add_u32 s40, s40, 950272
    s_addc_u32 s41, s41, 0
    s_add_u32 s44, s26, 851968
    s_addc_u32 s45, s27, 0
    v_and_b32 v26, 15, v0
    v_lshlrev_b32 v26, 4, v26
    v_lshrrev_b32 v5, 4, v0
    v_lshl_add_u32 v4, v5, 8, v26
    v_add_u32 v27, 4, v5
    v_cmp_eq_u32 vcc, 7, v27
    s_nop 1
    v_cndmask_b32 v27, v27, v5, vcc
    v_lshl_add_u32 v27, v27, 8, v26
    s_mov_b32 s48, 0x0
    s_mov_b32 s49, 0xffff0000
    v_and_b32 v6, 15, v0
    v_lshl_add_u32 v6, v6, 2, v5
    s_lshl_b32 s38, s37, 6
    v_add_u32 v6, s38, v6
    v_and_b32 v28, 7, v6
    v_lshlrev_b32 v28, 2, v28
    v_lshrrev_b32 v7, 3, v6
    v_lshl_add_u32 v7, v7, 5, v28
    v_lshlrev_b32 v6, 1, v6
    v_lshlrev_b32 v24, 3, v5
    v_lshrrev_b32 v24, v24, s28
    v_mov_b32 v29, 0
    s_mov_b32 s55, 400000
L_lp_9:
    global_load_dwordx4 v[8:11], v29, s[40:41] sc1
    s_waitcnt vmcnt(0)
    v_perm_b32 v68, v9, v8, s52
    v_perm_b32 v69, v11, v10, s53
    v_or_b32 v70, v68, v69
    v_xor_b32 v70, s28, v70
    v_cmp_ne_u32 vcc, 0, v70
    s_bcnt1_i32_b64 s39, vcc
    s_cmp_le_u32 s39, 0
    s_cbranch_scc1 L_lpx_10
    s_sleep 2
    s_sub_u32 s55, s55, 1
    s_cmp_lg_u32 s55, 0
    s_cbranch_scc1 L_lp_9
L_lpx_10:
    s_mov_b32 s55, 400000
L_poll_11:
    global_load_dwordx4 v[8:11], v4, s[40:41] sc1
    global_load_dwordx4 v[12:15], v27, s[40:41] sc1
    global_load_dword v16, v7, s[44:45] sc1
    s_waitcnt vmcnt(0)
    v_perm_b32 v68, v9, v8, s52
    v_perm_b32 v69, v11, v10, s53
    v_or_b32 v70, v68, v69
    v_perm_b32 v68, v13, v12, s52
    v_perm_b32 v69, v15, v14, s53
    v_or_b32 v68, v68, v69
    v_xor_b32 v68, v68, v70
    v_mov_b32 v71, v68
    v_xor_b32 v70, s28, v70
    v_or_b32 v70, v70, v71
    v_xor_b32 v68, v16, v24
    v_and_b32 v68, 0xff, v68
    v_or_b32 v70, v70, v68
    v_cmp_ne_u32 vcc, 0, v70
    s_cbranch_vccz L_pollx_12
    s_sleep 2
    s_sub_u32 s55, s55, 1
    s_cmp_lg_u32 s55, 0
    s_cbranch_scc1 L_poll_11
L_pollx_12:
    v_and_b32 v8, s54, v8
    v_and_b32 v9, s54, v9
    v_and_b32 v10, s54, v10
    v_and_b32 v11, s54, v11
    v_and_b32 v12, s54, v12
    v_and_b32 v13, s54, v13
    v_and_b32 v14, s54, v14
    v_and_b32 v15, s54, v15
    v_and_b32 v16, s54, v16
    v_cndmask_b32 v12, v12, 0, s[48:49]
    v_cndmask_b32 v13, v13, 0, s[48:49]
    v_cndmask_b32 v14, v14, 0, s[48:49]
    v_cndmask_b32 v15, v15, 0, s[48:49]
    v_add_f32 v8, v8, v12
    v_add_f32 v9, v9, v13
    v_add_f32 v10, v10, v14
    v_add_f32 v11, v11, v15
    s_nop 0
    v_permlane32_swap_b32 v8, v10
    v_permlane32_swap_b32 v9, v11
    v_add_f32 v8, v8, v10
    v_add_f32 v9, v9, v11
    s_nop 1
    v_permlane16_swap_b32 v8, v9
    v_add_f32 v8, v8, v9
    v_cvt_pk_bf16_f32 v68, v8, v8
    v_lshlrev_b32 v8, 16, v68
    v_add_f32 v8, v8, v16
    v_cvt_pk_bf16_f32 v8, v8, v8
    global_store_short v6, v8, s[22:23]
    s_cmp_lg_u32 s37, 0
    s_cbranch_scc1 L_F_noe
    v_mov_b32 v24, s98
    v_mov_b32 v25, 0
    s_mov_b64 exec, 1
    global_store_dword v25, v24, s[26:27] sc1
    s_mov_b64 exec, -1
L_F_noe:
L_HF_done:
    s_endpgm
L_P:
    v_lshrrev_b32 v24, 4, v0
    v_lshlrev_b32 v6, 1, v24
    v_and_b32 v7, 15, v0
    v_xor_b32 v6, v6, v7
    v_lshlrev_b32 v6, 4, v6
    v_lshl_add_u32 v6, v24, 8, v6
    v_xor_b32 v7, 0x80, v6
    s_lshl_b32 s38, s32, 12
    s_add_u32 s38, s38, 0
    s_mov_b32 m0, s38
    s_barrier
    global_load_lds_dwordx4 v7, s[50:51] offset:2048 nt
    global_load_lds_dwordx4 v7, s[50:51] offset:3072 nt
    s_and_b32 s38, s33, 7
    s_lshr_b32 s34, s38, 1
    s_lshr_b32 s38, s33, 3
    s_lshl_b32 s38, s38, 1
    s_and_b32 s39, s33, 1
    s_or_b32 s35, s38, s39
    s_lshl_b32 s38, s34, 14
    s_lshl_b32 s39, s32, 9
    s_add_u32 s38, s38, s39
    s_add_u32 s40, s26, s38
    s_addc_u32 s41, s27, 0
    s_add_u32 s40, s40, 4096
    s_addc_u32 s41, s41, 0
    v_lshrrev_b32 v4, 5, v0
    v_lshlrev_b32 v4, 13, v4
    v_and_b32 v5, 31, v0
    v_lshl_add_u32 v4, v5, 4, v4
    v_add_u32 v122, 0x1000, v4
    s_mul_i32 s38, s32, 272
    s_add_u32 s38, s38, 32768
    v_lshrrev_b32 v6, 5, v0
    v_lshlrev_b32 v6, 2, v6
    v_lshl_add_u32 v6, v5, 3, v6
    v_add_u32 v6, s38, v6
    v_and_b32 v7, 7, v0
    v_mul_u32_u24 v28, 272, v7
    v_and_b32 v25, 8, v0
    v_lshl_add_u32 v7, v25, 3, v28
    v_lshl_add_u32 v7, v24, 4, v7
    v_bfe_u32 v25, v0, 2, 2
    v_lshl_add_u32 v26, v24, 3, v25
    v_lshlrev_b32 v26, 8, v26
    v_and_b32 v30, 1, v24
    v_lshl_or_b32 v30, v30, 2, v25
    v_xor_b32 v30, s32, v30
    v_lshlrev_b32 v30, 5, v30
    v_bfe_u32 v25, v0, 1, 1
    v_lshl_add_u32 v30, v25, 4, v30
    v_and_b32 v25, 1, v0
    v_lshl_add_u32 v30, v25, 3, v30
    v_add_u32 v30, v30, v26
    v_and_b32 v26, 7, v0
    v_lshlrev_b32 v26, 5, v26
    s_lshl_b32 s38, s32, 2
    s_add_u32 s38, s38, 37376
    v_add_u32 v27, s38, v26
    v_cmp_lt_u32 vcc, 7, v0
    v_mov_b32 v1, 46336
    s_nop 0
    v_cndmask_b32 v27, v27, v1, vcc
    v_mov_b32 v104, 0x3f803f80
    v_and_b32 v1, 7, v0
    v_lshlrev_b32 v1, 2, v1
    ds_write_b32 v1, v104 offset:37888
    v_mov_b32 v105, 0x3f803f80
    v_mov_b32 v106, 0x3f803f80
    v_mov_b32 v107, 0x3f803f80
    v_lshl_add_u32 v29, v24, 3, v28
    s_lshl_b32 s38, s32, 5
    s_add_u32 s38, s38, 35072
    v_add_u32 v29, s38, v29
    v_and_b32 v25, 8, v0
    v_cmp_ne_u32 vcc, 0, v25
    v_mov_b32 v25, 46336
    s_nop 0
    v_cndmask_b32 v29, v29, v25, vcc
    v_lshl_add_u32 v31, v24, 4, v28
    s_lshl_b32 s38, s34, 17
    s_lshl_b32 s39, s35, 9
    s_add_u32 s38, s38, s39
    s_lshl_b32 s39, s32, 6
    s_add_u32 s38, s38, s39
    s_add_u32 s42, s26, s38
    s_addc_u32 s43, s27, 0
    s_add_u32 s42, s42, 131072
    s_addc_u32 s43, s43, 0
    s_lshl_b32 s38, s34, 12
    s_lshl_b32 s39, s35, 7
    s_add_u32 s38, s38, s39
    s_add_u32 s44, s26, s38
    s_addc_u32 s45, s27, 0
    s_add_u32 s44, s44, 655360
    s_addc_u32 s45, s45, 0
    v_and_b32 v120, 7, v0
    v_lshlrev_b32 v121, 4, v120
    v_lshlrev_b32 v120, 14, v120
    v_lshl_add_u32 v120, v24, 4, v120
    s_and_b32 s99, s33, 7
    s_min_u32 s38, s99, 6
    s_lshl_b32 s38, s38, 2
    s_lshr_b32 s39, s33, 5
    s_add_u32 s36, s38, s39
    s_bfe_u32 s37, s33, 0x20003
    s_lshl_b32 s38, s37, 8
    s_lshl_b32 s39, s32, 5
    s_add_u32 s38, s38, s39
    s_mul_i32 s38, s38, 7168
    s_lshl_b32 s39, s36, 8
    s_add_u32 s38, s38, s39
    s_add_u32 s46, s16, s38
    s_addc_u32 s47, s17, 0
    s_add_u32 s48, s18, s38
    s_addc_u32 s49, s19, 0
    v_lshlrev_b32 v125, 3, v24
    v_mul_u32_u24 v125, 7168, v125
    v_and_b32 v1, 15, v0
    v_lshl_add_u32 v125, v1, 4, v125
    s_waitcnt vmcnt(1)
    s_mov_b32 s55, 400000
L_poll_13:
    global_load_dwordx4 v[8:11], v4, s[40:41] sc1
    global_load_dwordx4 v[12:15], v122, s[40:41] sc1
    s_waitcnt vmcnt(0)
    v_perm_b32 v116, v9, v8, s52
    v_perm_b32 v117, v11, v10, s53
    v_or_b32 v118, v116, v117
    v_perm_b32 v116, v13, v12, s52
    v_perm_b32 v117, v15, v14, s53
    v_or_b32 v116, v116, v117
    v_xor_b32 v116, v116, v118
    v_mov_b32 v119, v116
    v_xor_b32 v118, s28, v118
    v_or_b32 v118, v118, v119
    v_cmp_ne_u32 vcc, 0, v118
    s_cbranch_vccz L_pollx_14
    s_sub_u32 s55, s55, 1
    s_cmp_lg_u32 s55, 0
    s_cbranch_scc1 L_poll_13
L_pollx_14:
    v_and_b32 v8, s54, v8
    v_and_b32 v9, s54, v9
    v_and_b32 v10, s54, v10
    v_and_b32 v11, s54, v11
    v_and_b32 v12, s54, v12
    v_and_b32 v13, s54, v13
    v_and_b32 v14, s54, v14
    v_and_b32 v15, s54, v15
    v_add_f32 v8, v8, v12
    v_add_f32 v9, v9, v13
    v_add_f32 v10, v10, v14
    v_add_f32 v11, v11, v15
    s_nop 0
    v_permlane32_swap_b32 v8, v10
    v_permlane32_swap_b32 v9, v11
    v_add_f32 v8, v8, v10
    v_add_f32 v9, v9, v11
    v_cvt_pk_bf16_f32 v8, v8, v9
    ds_write_b32 v6, v8
    s_cmp_eq_u32 s99, 7
    s_cbranch_scc1 L_nogpre
    global_load_dwordx4 v[32:35], v125, s[46:47] nt
    s_add_u32 s46, s46, 7168
    s_addc_u32 s47, s47, 0
    global_load_dwordx4 v[36:39], v125, s[46:47] nt
    s_add_u32 s46, s46, 7168
    s_addc_u32 s47, s47, 0
    global_load_dwordx4 v[40:43], v125, s[46:47] nt
    s_add_u32 s46, s46, 7168
    s_addc_u32 s47, s47, 0
    global_load_dwordx4 v[44:47], v125, s[46:47] nt
    s_add_u32 s46, s46, 7168
    s_addc_u32 s47, s47, 0
L_nogpre:
    s_waitcnt lgkmcnt(0)
    s_barrier
    ds_read_b128 v[80:83], v7 offset:32768
    ds_read_b128 v[84:87], v7 offset:32896
    ds_read_b64_tr_b16 v[64:65], v30 offset:0
    ds_read_b64_tr_b16 v[66:67], v30 offset:1024
    ds_read_b64_tr_b16 v[68:69], v30 offset:8192
    ds_read_b64_tr_b16 v[70:71], v30 offset:9216
    ds_read_b64_tr_b16 v[72:73], v30 offset:16384
    ds_read_b64_tr_b16 v[74:75], v30 offset:17408
    ds_read_b64_tr_b16 v[76:77], v30 offset:24576
    ds_read_b64_tr_b16 v[78:79], v30 offset:25600
    s_waitcnt lgkmcnt(9)
    v_mfma_f32_16x16x32_bf16 v[88:91], v[48:51], v[80:83], 0
    v_mfma_f32_16x16x32_bf16 v[92:95], v[56:59], v[80:83], 0
    s_waitcnt lgkmcnt(8)
    v_mfma_f32_16x16x32_bf16 v[88:91], v[52:55], v[84:87], v[88:91]
    v_mfma_f32_16x16x32_bf16 v[92:95], v[60:63], v[84:87], v[92:95]
    s_nop 7
    v_permlane32_swap_b32 v88, v92
    v_permlane32_swap_b32 v89, v93
    v_permlane32_swap_b32 v90, v94
    v_permlane32_swap_b32 v91, v95
    v_add_f32_dpp v88, v92, v88 row_ror:8 row_mask:0xf bank_mask:0xf
    v_add_f32_dpp v89, v93, v89 row_ror:8 row_mask:0xf bank_mask:0xf
    v_add_f32_dpp v90, v94, v90 row_ror:8 row_mask:0xf bank_mask:0xf
    v_add_f32_dpp v91, v95, v91 row_ror:8 row_mask:0xf bank_mask:0xf
    v_cvt_pk_bf16_f32 v92, v88, v89
    v_cvt_pk_bf16_f32 v93, v90, v91
    v_lshlrev_b32 v88, 16, v92
    v_and_b32 v89, 0xffff0000, v92
    v_lshlrev_b32 v90, 16, v93
    v_and_b32 v91, 0xffff0000, v93
    v_mul_f32 v88, s97, v88
    v_mul_f32 v89, s97, v89
    v_mul_f32 v90, s97, v90
    v_mul_f32 v91, s97, v91
    v_cvt_pk_bf16_f32 v92, v88, v89
    v_cvt_pk_bf16_f32 v93, v90, v91
    v_lshlrev_b32 v88, 16, v92
    v_and_b32 v89, 0xffff0000, v92
    v_lshlrev_b32 v90, 16, v93
    v_and_b32 v91, 0xffff0000, v93
    v_max3_f32 v16, v88, v89, v90
    v_max_f32 v16, v16, v91
    v_mov_b32 v17, v16
    s_nop 1
    v_permlane16_swap_b32 v17, v16
    v_max_f32 v16, v16, v17
    v_mov_b32 v17, v16
    s_nop 1
    v_permlane32_swap_b32 v17, v16
    v_max_f32 v16, v16, v17
    ds_write_b32 v27, v16
    v_mul_f32 v92, s96, v88
    v_mul_f32 v93, s96, v89
    v_mul_f32 v94, s96, v90
    v_mul_f32 v95, s96, v91
    s_waitcnt lgkmcnt(0)
    s_barrier
    ds_read_b128 v[8:11], v26 offset:37376
    ds_read_b128 v[12:15], v26 offset:37392
    s_waitcnt lgkmcnt(0)
    v_max3_f32 v8, v8, v9, v10
    v_max3_f32 v11, v11, v12, v13
    v_max3_f32 v8, v8, v14, v15
    v_max_f32 v8, v8, v11
    v_mul_f32 v9, s96, v8
    v_sub_f32 v88, v92, v9
    v_sub_f32 v89, v93, v9
    v_sub_f32 v90, v94, v9
    v_sub_f32 v91, v95, v9
    v_exp_f32 v88, v88
    v_exp_f32 v89, v89
    v_exp_f32 v90, v90
    v_exp_f32 v91, v91
    v_cvt_pk_bf16_f32 v92, v88, v89
    v_cvt_pk_bf16_f32 v93, v90, v91
    ds_write_b64 v29, v[92:93]
    s_waitcnt lgkmcnt(0)
    s_barrier
    ds_read_b128 v[48:51], v31 offset:35072
    ds_read_b128 v[52:55], v31 offset:35136
    ds_read_b128 v[56:59], v31 offset:35200
    ds_read_b128 v[60:63], v31 offset:35264
    s_waitcnt lgkmcnt(3)
    v_mfma_f32_16x16x32_bf16 v[96:99], v[64:67], v[48:51], 0
    s_waitcnt lgkmcnt(2)
    v_mfma_f32_16x16x32_bf16 v[96:99], v[68:71], v[52:55], v[96:99]
    s_waitcnt lgkmcnt(1)
    v_mfma_f32_16x16x32_bf16 v[96:99], v[72:75], v[56:59], v[96:99]
    s_waitcnt lgkmcnt(0)
    v_mfma_f32_16x16x32_bf16 v[96:99], v[76:79], v[60:63], v[96:99]
    s_cmp_lg_u32 s32, 0
    s_cbranch_scc1 L_A_nol
    v_mfma_f32_16x16x32_bf16 v[100:103], v[104:107], v[48:51], 0
    v_mfma_f32_16x16x32_bf16 v[100:103], v[104:107], v[52:55], v[100:103]
    v_mfma_f32_16x16x32_bf16 v[100:103], v[104:107], v[56:59], v[100:103]
    v_mfma_f32_16x16x32_bf16 v[100:103], v[104:107], v[60:63], v[100:103]
L_A_nol:
    s_nop 5
    v_bfi_b32 v96, v2, s28, v96
    v_bfi_b32 v97, v2, s29, v97
    v_bfi_b32 v98, v2, s30, v98
    v_bfi_b32 v99, v2, s31, v99
    s_mov_b64 exec, s[14:15]
    global_store_dwordx4 v120, v[96:99], s[42:43] sc1
    s_mov_b64 exec, -1
    s_cmp_lg_u32 s32, 0
    s_cbranch_scc1 L_A_skip
    v_mov_b32 v9, v100
    v_mov_b32 v10, 0
    v_mov_b32 v11, 0
    v_bfi_b32 v8, v2, s28, v8
    v_bfi_b32 v9, v2, s29, v9
    v_bfi_b32 v10, v2, s30, v10
    v_bfi_b32 v11, v2, s31, v11
    s_mov_b64 exec, s[0:1]
    global_store_dwordx4 v121, v[8:11], s[44:45] sc1
    s_mov_b64 exec, -1
L_A_skip:
    s_barrier
    s_cmp_eq_u32 s99, 7
    s_cbranch_scc1 L_P_done
    s_and_b32 s38, s36, 3
    s_cmp_eq_u32 s38, 1
    s_cbranch_scc1 L_G_fast
    global_load_dwordx4 v[48:51], v125, s[46:47] nt
    s_add_u32 s46, s46, 7168
    s_addc_u32 s47, s47, 0
    global_load_dwordx4 v[52:55], v125, s[46:47] nt
    s_add_u32 s46, s46, 7168
    s_addc_u32 s47, s47, 0
    s_waitcnt vmcnt(1)
    global_load_dwordx4 v[56:59], v125, s[46:47] nt
    s_add_u32 s46, s46, 7168
    s_addc_u32 s47, s47, 0
    s_waitcnt vmcnt(1)
    global_load_dwordx4 v[60:63], v125, s[46:47] nt
    s_waitcnt vmcnt(1)
    global_load_dwordx4 v[64:67], v125, s[48:49] nt
    s_add_u32 s48, s48, 7168
    s_addc_u32 s49, s49, 0
    global_load_dwordx4 v[68:71], v125, s[48:49] nt
    s_add_u32 s48, s48, 7168
    s_addc_u32 s49, s49, 0
    global_load_dwordx4 v[72:75], v125, s[48:49] nt
    s_add_u32 s48, s48, 7168
    s_addc_u32 s49, s49, 0
    global_load_dwordx4 v[76:79], v125, s[48:49] nt
    s_add_u32 s48, s48, 7168
    s_addc_u32 s49, s49, 0
    global_load_dwordx4 v[80:83], v125, s[48:49] nt
    s_add_u32 s48, s48, 7168
    s_addc_u32 s49, s49, 0
    global_load_dwordx4 v[84:87], v125, s[48:49] nt
    s_add_u32 s48, s48, 7168
    s_addc_u32 s49, s49, 0
    global_load_dwordx4 v[88:91], v125, s[48:49] nt
    s_add_u32 s48, s48, 7168
    s_addc_u32 s49, s49, 0
    global_load_dwordx4 v[92:95], v125, s[48:49] nt
    s_branch L_G_issued
L_G_fast:
    global_load_dwordx4 v[48:51], v125, s[46:47] nt
    s_add_u32 s46, s46, 7168
    s_addc_u32 s47, s47, 0
    global_load_dwordx4 v[52:55], v125, s[46:47] nt
    s_add_u32 s46, s46, 7168
    s_addc_u32 s47, s47, 0
    global_load_dwordx4 v[56:59], v125, s[46:47] nt
    s_add_u32 s46, s46, 7168
    s_addc_u32 s47, s47, 0
    global_load_dwordx4 v[60:63], v125, s[46:47] nt
    global_load_dwordx4 v[64:67], v125, s[48:49] nt
    s_add_u32 s48, s48, 7168
    s_addc_u32 s49, s49, 0
    global_load_dwordx4 v[68:71], v125, s[48:49] nt
    s_add_u32 s48, s48, 7168
    s_addc_u32 s49, s49, 0
    global_load_dwordx4 v[72:75], v125, s[48:49] nt
    s_add_u32 s48, s48, 7168
    s_addc_u32 s49, s49, 0
    global_load_dwordx4 v[76:79], v125, s[48:49] nt
    s_add_u32 s48, s48, 7168
    s_addc_u32 s49, s49, 0
    global_load_dwordx4 v[80:83], v125, s[48:49] nt
    s_add_u32 s48, s48, 7168
    s_addc_u32 s49, s49, 0
    global_load_dwordx4 v[84:87], v125, s[48:49] nt
    s_add_u32 s48, s48, 7168
    s_addc_u32 s49, s49, 0
    global_load_dwordx4 v[88:91], v125, s[48:49] nt
    s_add_u32 s48, s48, 7168
    s_addc_u32 s49, s49, 0
    global_load_dwordx4 v[92:95], v125, s[48:49] nt
L_G_issued:
    s_lshl_b32 s38, s32, 9
    s_add_u32 s40, s26, s38
    s_addc_u32 s41, s27, 0
    s_add_u32 s40, s40, 851968
    s_addc_u32 s41, s41, 0
    s_lshl_b32 s38, s32, 9
    v_and_b32 v5, 31, v0
    v_lshlrev_b32 v5, 4, v5
    s_add_u32 s38, s38, 38144
    v_add_u32 v6, s38, v5
    v_bfe_u32 v5, v0, 1, 4
    v_lshlrev_b32 v5, 5, v5
    v_and_b32 v1, 1, v0
    v_lshl_add_u32 v5, v1, 4, v5
    v_mov_b32 v1, 46336
    v_cndmask_b32 v6, v1, v6, s[60:61]
    s_lshl_b32 s38, s32, 4
    s_add_u32 s38, s38, 37632
    v_mov_b32 v26, s38
    v_mov_b32 v1, 46592
    v_cmp_eq_u32 vcc, 63, v0
    s_nop 1
    v_cndmask_b32 v26, v1, v26, vcc
    v_and_b32 v27, 7, v0
    v_lshlrev_b32 v27, 4, v27
    s_lshl_b32 s38, s37, 10
    s_lshl_b32 s39, s32, 7
    s_add_u32 s38, s38, s39
    s_add_u32 s38, s38, 38144
    v_lshl_add_u32 v25, v24, 5, s38
    v_and_b32 v1, 8, v0
    v_cmp_ne_u32 vcc, 0, v1
    v_mov_b32 v1, 37888
    s_nop 0
    v_cndmask_b32 v25, v25, v1, vcc
    v_and_b32 v7, 7, v0
    v_lshlrev_b32 v7, 2, v7
    v_lshl_add_u32 v7, v24, 7, v7
    s_lshl_b32 s38, s32, 9
    v_add_u32 v7, s38, v7
    v_add_u32 v28, 4096, v7
    v_and_b32 v31, 8, v0
    v_cmp_ne_u32 vcc, 0, v31
    v_mov_b32 v31, 46336
    s_nop 0
    v_cndmask_b32 v7, v7, v31, vcc
    v_and_b32 v31, 8, v0
    v_cmp_ne_u32 vcc, 0, v31
    v_mov_b32 v31, 46336
    s_nop 0
    v_cndmask_b32 v28, v28, v31, vcc
    s_lshl_b32 s38, s36, 12
    s_lshl_b32 s39, s37, 10
    s_add_u32 s38, s38, s39
    s_lshl_b32 s39, s32, 8
    s_add_u32 s38, s38, s39
    s_add_u32 s42, s26, s38
    s_addc_u32 s43, s27, 0
    s_add_u32 s42, s42, 1114112
    s_addc_u32 s43, s43, 0
    s_add_u32 s44, s26, s38
    s_addc_u32 s45, s27, 0
    s_add_u32 s44, s44, 1245184
    s_addc_u32 s45, s45, 0
    s_lshr_b32 s38, s32, 1
    s_lshl_b32 s38, s38, 12
    s_and_b32 s39, s32, 1
    s_lshl_b32 s39, s39, 8
    s_add_u32 s38, s38, s39
    v_lshl_add_u32 v29, v0, 2, s38
    v_lshlrev_b32 v30, 2, v0
    s_mov_b32 s99, 0x03020302
    s_waitcnt vmcnt(2)
    s_mov_b32 s55, 400000
L_poll_15:
    global_load_dwordx4 v[8:11], v5, s[40:41] sc1
    s_waitcnt vmcnt(0)
    v_perm_b32 v104, v9, v8, s52
    v_perm_b32 v105, v11, v10, s53
    v_or_b32 v106, v104, v105
    v_xor_b32 v106, s28, v106
    v_cmp_ne_u32 vcc, 0, v106
    s_cbranch_vccz L_pollx_16
    s_sleep 2
    s_sub_u32 s55, s55, 1
    s_cmp_lg_u32 s55, 0
    s_cbranch_scc1 L_poll_15
L_pollx_16:
    v_perm_b32 v20, v8, v8, s99
    v_perm_b32 v21, v9, v9, s99
    v_perm_b32 v22, v10, v10, s99
    v_perm_b32 v23, v11, v11, s99
    ds_write_b128 v6, v[20:23]
    v_and_b32 v8, s54, v8
    v_and_b32 v9, s54, v9
    v_and_b32 v10, s54, v10
    v_and_b32 v11, s54, v11
    v_readfirstlane_b32 s38, v8
    v_cndmask_b32 v12, v10, v8, s[60:61]
    v_cndmask_b32 v13, v11, v9, s[60:61]
    v_subrev_f32 v12, s38, v12
    v_subrev_f32 v13, s38, v13
    v_add_f32 v17, v12, v13
    v_mul_f32 v18, v12, v12
    v_fmac_f32 v18, v13, v13
    v_mov_b32 v16, s38
    v_add_f32_dpp v17, v17, v17 quad_perm:[1,0,3,2] row_mask:0xf bank_mask:0xf
    v_add_f32_dpp v18, v18, v18 quad_perm:[1,0,3,2] row_mask:0xf bank_mask:0xf
    s_nop 0
    v_add_f32_dpp v17, v17, v17 quad_perm:[2,3,0,1] row_mask:0xf bank_mask:0xf
    v_add_f32_dpp v18, v18, v18 quad_perm:[2,3,0,1] row_mask:0xf bank_mask:0xf
    s_nop 0
    v_add_f32_dpp v17, v17, v17 row_ror:4 row_mask:0xf bank_mask:0xf
    v_add_f32_dpp v18, v18, v18 row_ror:4 row_mask:0xf bank_mask:0xf
    s_nop 0
    v_add_f32_dpp v17, v17, v17 row_ror:8 row_mask:0xf bank_mask:0xf
    v_add_f32_dpp v18, v18, v18 row_ror:8 row_mask:0xf bank_mask:0xf
    s_nop 0
    v_add_f32_dpp v17, v17, v17 row_bcast:15 row_mask:0xa bank_mask:0xf
    v_add_f32_dpp v18, v18, v18 row_bcast:15 row_mask:0xa bank_mask:0xf
    s_nop 0
    v_add_f32_dpp v17, v17, v17 row_bcast:31 row_mask:0xc bank_mask:0xf
    v_add_f32_dpp v18, v18, v18 row_bcast:31 row_mask:0xc bank_mask:0xf
    ds_write_b96 v26, v[16:18]
    s_waitcnt lgkmcnt(0)
    s_barrier
    ds_read_b128 v[104:107], v25
    ds_read_b128 v[108:111], v25 offset:16
    ds_read_b128 v[8:11], v27 offset:37632
    s_waitcnt lgkmcnt(1)
    v_and_b32 v116, v104, v112
    v_and_b32 v117, v104, v113
    v_and_b32 v118, v104, v114
    v_and_b32 v119, v104, v115
    s_nop 1
    v_mfma_f32_16x16x32_bf16 v[96:99], v[32:35], v[116:119], 0
    v_mfma_f32_16x16x32_bf16 v[100:103], v[64:67], v[116:119], 0
    s_waitcnt lgkmcnt(0)
    v_mul_f32 v12, 0x3c000000, v9
    v_add_f32 v8, v8, v12
    v_fma_f32 v10, -v12, v9, v10
    v_and_b32 v120, v105, v112
    v_and_b32 v121, v105, v113
    v_and_b32 v122, v105, v114
    v_and_b32 v123, v105, v115
    s_nop 1
    v_mfma_f32_16x16x32_bf16 v[96:99], v[36:39], v[120:123], v[96:99]
    v_mfma_f32_16x16x32_bf16 v[100:103], v[68:71], v[120:123], v[100:103]
    v_mov_b32 v13, v8
    s_nop 1
    v_add_f32_dpp v13, v13, v13 quad_perm:[1,0,3,2] row_mask:0xf bank_mask:0xf
    s_nop 1
    v_add_f32_dpp v13, v13, v13 quad_perm:[2,3,0,1] row_mask:0xf bank_mask:0xf
    s_nop 1
    v_add_f32_dpp v13, v13, v13 row_half_mirror row_mask:0xf bank_mask:0xf
    v_and_b32 v116, v106, v112
    v_and_b32 v117, v106, v113
    v_and_b32 v118, v106, v114
    v_and_b32 v119, v106, v115
    s_nop 1
    v_mfma_f32_16x16x32_bf16 v[96:99], v[40:43], v[116:119], v[96:99]
    v_mfma_f32_16x16x32_bf16 v[100:103], v[72:75], v[116:119], v[100:103]
    v_mul_f32 v13, 0x3e000000, v13
    v_sub_f32 v8, v8, v13
    v_mul_f32 v8, v8, v8
    v_fmac_f32 v10, 0x43000000, v8
    v_and_b32 v120, v107, v112
    v_and_b32 v121, v107, v113
    v_and_b32 v122, v107, v114
    v_and_b32 v123, v107, v115
    s_nop 1
    v_mfma_f32_16x16x32_bf16 v[96:99], v[44:47], v[120:123], v[96:99]
    v_mfma_f32_16x16x32_bf16 v[100:103], v[76:79], v[120:123], v[100:103]
    v_add_f32_dpp v10, v10, v10 quad_perm:[1,0,3,2] row_mask:0xf bank_mask:0xf
    s_nop 1
    v_add_f32_dpp v10, v10, v10 quad_perm:[2,3,0,1] row_mask:0xf bank_mask:0xf
    s_nop 1
    v_add_f32_dpp v10, v10, v10 row_half_mirror row_mask:0xf bank_mask:0xf
    v_mul_f32 v10, 0x3a800000, v10
    v_and_b32 v116, v108, v112
    v_and_b32 v117, v108, v113
    v_and_b32 v118, v108, v114
    v_and_b32 v119, v108, v115
    s_nop 1
    v_mfma_f32_16x16x32_bf16 v[96:99], v[48:51], v[116:119], v[96:99]
    v_mfma_f32_16x16x32_bf16 v[100:103], v[80:83], v[116:119], v[100:103]
    v_cvt_pk_bf16_f32 v14, v10, v10
    v_lshlrev_b32 v10, 16, v14
    v_add_f32 v10, 0x3727c5ac, v10
    v_cvt_pk_bf16_f32 v14, v10, v10
    v_and_b32 v120, v109, v112
    v_and_b32 v121, v109, v113
    v_and_b32 v122, v109, v114
    v_and_b32 v123, v109, v115
    s_nop 1
    v_mfma_f32_16x16x32_bf16 v[96:99], v[52:55], v[120:123], v[96:99]
    v_mfma_f32_16x16x32_bf16 v[100:103], v[84:87], v[120:123], v[100:103]
    v_lshlrev_b32 v10, 16, v14
    v_sqrt_f32 v10, v10
    v_cvt_pk_bf16_f32 v15, v13, v13
    v_lshlrev_b32 v13, 16, v15
    v_and_b32 v116, v110, v112
    v_and_b32 v117, v110, v113
    v_and_b32 v118, v110, v114
    v_and_b32 v119, v110, v115
    s_nop 1
    v_mfma_f32_16x16x32_bf16 v[96:99], v[56:59], v[116:119], v[96:99]
    v_mfma_f32_16x16x32_bf16 v[100:103], v[88:91], v[116:119], v[100:103]
    v_xor_b32 v13, 0x80000000, v13
    v_cvt_pk_bf16_f32 v14, v10, v10
    v_lshlrev_b32 v10, 16, v14
    v_rcp_f32 v11, v10
    v_and_b32 v120, v111, v112
    v_and_b32 v121, v111, v113
    v_and_b32 v122, v111, v114
    v_and_b32 v123, v111, v115
    s_nop 1
    v_mfma_f32_16x16x32_bf16 v[96:99], v[60:63], v[120:123], v[96:99]
    v_mfma_f32_16x16x32_bf16 v[100:103], v[92:95], v[120:123], v[100:103]
    s_nop 6
    v_fmac_f32_dpp v96, v96, v13 row_ror:8 row_mask:0xf bank_mask:0xf
    v_fmac_f32_dpp v97, v97, v13 row_ror:8 row_mask:0xf bank_mask:0xf
    v_fmac_f32_dpp v98, v98, v13 row_ror:8 row_mask:0xf bank_mask:0xf
    v_fmac_f32_dpp v99, v99, v13 row_ror:8 row_mask:0xf bank_mask:0xf
    v_fmac_f32_dpp v100, v100, v13 row_ror:8 row_mask:0xf bank_mask:0xf
    v_fmac_f32_dpp v101, v101, v13 row_ror:8 row_mask:0xf bank_mask:0xf
    v_fmac_f32_dpp v102, v102, v13 row_ror:8 row_mask:0xf bank_mask:0xf
    v_fmac_f32_dpp v103, v103, v13 row_ror:8 row_mask:0xf bank_mask:0xf
    v_mul_f32 v96, v96, v11
    v_mul_f32 v97, v97, v11
    v_mul_f32 v98, v98, v11
    v_mul_f32 v99, v99, v11
    v_mul_f32 v100, v100, v11
    v_mul_f32 v101, v101, v11
    v_mul_f32 v102, v102, v11
    v_mul_f32 v103, v103, v11
    ds_write_b32 v7, v96 offset:0
    ds_write_b32 v7, v97 offset:32
    ds_write_b32 v7, v98 offset:64
    ds_write_b32 v7, v99 offset:96
    ds_write_b32 v28, v100 offset:0
    ds_write_b32 v28, v101 offset:32
    ds_write_b32 v28, v102 offset:64
    ds_write_b32 v28, v103 offset:96
    s_waitcnt lgkmcnt(0)
    s_barrier
    s_cmp_ge_u32 s32, 4
    s_cbranch_scc1 L_P_done
    ds_read2st64_b32 v[8:9], v29 offset0:0 offset1:2
    ds_read2st64_b32 v[10:11], v29 offset0:4 offset1:6
    ds_read2st64_b32 v[12:13], v29 offset0:8 offset1:10
    ds_read2st64_b32 v[14:15], v29 offset0:12 offset1:14
    s_waitcnt lgkmcnt(0)
    v_add_f32 v8, v8, v12
    v_add_f32 v9, v9, v13
    v_add_f32 v10, v10, v14
    v_add_f32 v11, v11, v15
    v_add_f32 v8, v8, v10
    v_add_f32 v9, v9, v11
    v_add_f32 v8, v8, v9
    v_add_u32 v8, 0x80, v8
    v_bfi_b32 v8, v2, v3, v8
    s_nop 1
    v_mov_b32_dpp v9, v8 quad_perm:[1,1,1,1] row_mask:0xf bank_mask:0xf
    v_mov_b32_dpp v10, v8 quad_perm:[2,2,2,2] row_mask:0xf bank_mask:0xf
    v_mov_b32_dpp v11, v8 quad_perm:[3,3,3,3] row_mask:0xf bank_mask:0xf
    s_mov_b64 exec, s[62:63]
    global_store_dwordx4 v30, v[8:11], s[44:45]
    global_store_dwordx4 v30, v[8:11], s[42:43] sc1
    s_mov_b64 exec, -1
L_P_done:
L_end:
    s_endpgm
.section .rodata,"a"
.p2align 6
.amdhsa_kernel sequential_preLN__sliding_block_cached__glu_gated_reglu__decode_kernel
  .amdhsa_next_free_vgpr 128
  .amdhsa_next_free_sgpr 102
  .amdhsa_accum_offset 128
  .amdhsa_group_segment_fixed_size 0
  .amdhsa_kernarg_size 96
  .amdhsa_user_sgpr_count 2
  .amdhsa_user_sgpr_kernarg_segment_ptr 1
  .amdhsa_system_sgpr_workgroup_id_x 1
  .amdhsa_float_denorm_mode_32 3
.end_amdhsa_kernel
```
